```python
import torch

def _softmax(x, axis=-1):
    return torch.softmax(x, dim=axis)
def _gelu(x):
    return torch.nn.functional.gelu(x, approximate="tanh")
def _silu(x):
    return torch.nn.functional.silu(x)
def _sigmoid(x):
    return torch.sigmoid(x)
def _layernorm(x, axis=-1, eps=1e-5):
    m = x.mean(dim=axis, keepdim=True)
    v = x.var(dim=axis, keepdim=True, unbiased=False)
    return (x - m) / torch.sqrt(v + eps)
def _scatter_add(tgt, idx, src, axis=0):
    return tgt.clone().index_add_(axis, idx, src)
def _segment_sum(src, seg, n):
    out = torch.zeros((n,) + src.shape[1:], dtype=src.dtype)
    return out.index_add_(0, seg, src)
def _pad(x, pw):
    flat = tuple(v for pair in reversed(pw) for v in pair)
    return torch.nn.functional.pad(x, flat)

kernel_name = 'standalone__grn__sampling'

def setup_inputs():

    _w = (lambda a: (lambda t: t.to(torch.bfloat16) if t.is_floating_point() else t)(torch.as_tensor(a)))
    B, S, D = 1024, 16, 1024
    return {
        "x": _w((lambda *s: torch.randn(*s, dtype=torch.bfloat16) * 0.05)(B, S, D)),
        "g": _w((lambda *s: torch.randn(*s, dtype=torch.bfloat16) * 0.4)(D) * 0.1),
        "b": _w((lambda *s: torch.randn(*s, dtype=torch.bfloat16) * 0.1)(D) * 0.1),
    }

def reference(x, g, b):
    gx = torch.sqrt((x * x).sum(axis=-2, keepdims=True))
    nx = gx / (gx.mean(axis=-1, keepdims=True) + 1e-6)
    return g * (x * nx) + b + x
```

```asm
; @launch grid=(1024,1,1) block=(256,1,1) lds=16
.amdgcn_target "amdgcn-amd-amdhsa--gfx950"
.text
.globl standalone__grn__sampling_kernel
.p2align 8
.type standalone__grn__sampling_kernel,@function
standalone__grn__sampling_kernel:
  s_load_dwordx2 s[4:5], s[0:1], 0
  s_load_dwordx2 s[8:9], s[0:1], 8
  s_load_dwordx2 s[12:13], s[0:1], 16
  s_load_dwordx2 s[16:17], s[0:1], 24
  s_cmpk_ge_u32 s2, 1024
  s_cbranch_scc1 L_end
  s_setprio 3
  s_lshl_b32 s3, s2, 15
  v_and_b32 v2, 31, v0
  v_lshrrev_b32 v3, 6, v0
  v_lshlrev_b32 v2, 4, v2
  v_bfe_u32 v1, v0, 5, 1
  v_lshl_add_u32 v2, v3, 9, v2
  v_lshl_add_u32 v1, v1, 11, s3
  v_add_u32 v1, v1, v2
  s_mov_b32 s6, 0x2000000
  s_mov_b32 s7, 0x20000
  s_movk_i32 s21, 4096
  s_movk_i32 s22, 8192
  s_movk_i32 s23, 12288
  s_movk_i32 s24, 16384
  s_movk_i32 s25, 20480
  s_movk_i32 s26, 24576
  s_movk_i32 s27, 28672
  s_movk_i32 s10, 2048
  s_mov_b32 s11, s7
  s_movk_i32 s14, 2048
  s_mov_b32 s15, s7
  s_waitcnt lgkmcnt(0)
  buffer_load_dwordx4 v[72:75], v2, s[8:11], 0 offen
  buffer_load_dwordx4 v[80:83], v2, s[12:15], 0 offen
  buffer_load_dwordx4 v[8:11], v1, s[4:7], 0 offen nt
  buffer_load_dwordx4 v[16:19], v1, s[4:7], s21 offen nt
  buffer_load_dwordx4 v[24:27], v1, s[4:7], s22 offen nt
  buffer_load_dwordx4 v[32:35], v1, s[4:7], s23 offen nt
  buffer_load_dwordx4 v[40:43], v1, s[4:7], s24 offen nt
  buffer_load_dwordx4 v[48:51], v1, s[4:7], s25 offen nt
  buffer_load_dwordx4 v[56:59], v1, s[4:7], s26 offen nt
  buffer_load_dwordx4 v[64:67], v1, s[4:7], s27 offen nt
  s_setprio 0
  s_mov_b32 s18, s6
  s_mov_b32 s19, s7
  s_mov_b32 s20, 0xffff0000
  v_lshlrev_b32 v0, 2, v3
  s_waitcnt vmcnt(8)
  v_lshlrev_b32 v68, 16, v72
  v_and_b32 v69, s20, v72
  v_lshlrev_b32 v70, 16, v73
  v_and_b32 v71, s20, v73
  v_lshlrev_b32 v72, 16, v74
  v_and_b32 v73, s20, v74
  v_lshlrev_b32 v74, 16, v75
  v_and_b32 v75, s20, v75
  v_lshlrev_b32 v76, 16, v80
  v_and_b32 v77, s20, v80
  v_lshlrev_b32 v78, 16, v81
  v_and_b32 v79, s20, v81
  v_lshlrev_b32 v80, 16, v82
  v_and_b32 v81, s20, v82
  v_lshlrev_b32 v82, 16, v83
  v_and_b32 v83, s20, v83
  s_waitcnt vmcnt(7)
  v_lshlrev_b32 v4, 16, v8
  v_and_b32 v5, s20, v8
  v_lshlrev_b32 v6, 16, v9
  v_and_b32 v7, s20, v9
  v_lshlrev_b32 v8, 16, v10
  v_and_b32 v9, s20, v10
  v_lshlrev_b32 v10, 16, v11
  v_and_b32 v11, s20, v11
  v_pk_mul_f32 v[84:85], v[4:5], v[4:5]
  v_pk_mul_f32 v[86:87], v[6:7], v[6:7]
  v_pk_mul_f32 v[88:89], v[8:9], v[8:9]
  v_pk_mul_f32 v[90:91], v[10:11], v[10:11]
  s_waitcnt vmcnt(6)
  v_lshlrev_b32 v12, 16, v16
  v_and_b32 v13, s20, v16
  v_lshlrev_b32 v14, 16, v17
  v_and_b32 v15, s20, v17
  v_lshlrev_b32 v16, 16, v18
  v_and_b32 v17, s20, v18
  v_lshlrev_b32 v18, 16, v19
  v_and_b32 v19, s20, v19
  v_pk_fma_f32 v[84:85], v[12:13], v[12:13], v[84:85]
  v_pk_fma_f32 v[86:87], v[14:15], v[14:15], v[86:87]
  v_pk_fma_f32 v[88:89], v[16:17], v[16:17], v[88:89]
  v_pk_fma_f32 v[90:91], v[18:19], v[18:19], v[90:91]
  s_waitcnt vmcnt(5)
  v_lshlrev_b32 v20, 16, v24
  v_and_b32 v21, s20, v24
  v_lshlrev_b32 v22, 16, v25
  v_and_b32 v23, s20, v25
  v_lshlrev_b32 v24, 16, v26
  v_and_b32 v25, s20, v26
  v_lshlrev_b32 v26, 16, v27
  v_and_b32 v27, s20, v27
  v_pk_fma_f32 v[84:85], v[20:21], v[20:21], v[84:85]
  v_pk_fma_f32 v[86:87], v[22:23], v[22:23], v[86:87]
  v_pk_fma_f32 v[88:89], v[24:25], v[24:25], v[88:89]
  v_pk_fma_f32 v[90:91], v[26:27], v[26:27], v[90:91]
  s_waitcnt vmcnt(4)
  v_lshlrev_b32 v28, 16, v32
  v_and_b32 v29, s20, v32
  v_lshlrev_b32 v30, 16, v33
  v_and_b32 v31, s20, v33
  v_lshlrev_b32 v32, 16, v34
  v_and_b32 v33, s20, v34
  v_lshlrev_b32 v34, 16, v35
  v_and_b32 v35, s20, v35
  v_pk_fma_f32 v[84:85], v[28:29], v[28:29], v[84:85]
  v_pk_fma_f32 v[86:87], v[30:31], v[30:31], v[86:87]
  v_pk_fma_f32 v[88:89], v[32:33], v[32:33], v[88:89]
  v_pk_fma_f32 v[90:91], v[34:35], v[34:35], v[90:91]
  s_waitcnt vmcnt(3)
  v_lshlrev_b32 v36, 16, v40
  v_and_b32 v37, s20, v40
  v_lshlrev_b32 v38, 16, v41
  v_and_b32 v39, s20, v41
  v_lshlrev_b32 v40, 16, v42
  v_and_b32 v41, s20, v42
  v_lshlrev_b32 v42, 16, v43
  v_and_b32 v43, s20, v43
  v_pk_fma_f32 v[84:85], v[36:37], v[36:37], v[84:85]
  v_pk_fma_f32 v[86:87], v[38:39], v[38:39], v[86:87]
  v_pk_fma_f32 v[88:89], v[40:41], v[40:41], v[88:89]
  v_pk_fma_f32 v[90:91], v[42:43], v[42:43], v[90:91]
  s_waitcnt vmcnt(2)
  v_lshlrev_b32 v44, 16, v48
  v_and_b32 v45, s20, v48
  v_lshlrev_b32 v46, 16, v49
  v_and_b32 v47, s20, v49
  v_lshlrev_b32 v48, 16, v50
  v_and_b32 v49, s20, v50
  v_lshlrev_b32 v50, 16, v51
  v_and_b32 v51, s20, v51
  v_pk_fma_f32 v[84:85], v[44:45], v[44:45], v[84:85]
  v_pk_fma_f32 v[86:87], v[46:47], v[46:47], v[86:87]
  v_pk_fma_f32 v[88:89], v[48:49], v[48:49], v[88:89]
  v_pk_fma_f32 v[90:91], v[50:51], v[50:51], v[90:91]
  s_waitcnt vmcnt(1)
  v_lshlrev_b32 v52, 16, v56
  v_and_b32 v53, s20, v56
  v_lshlrev_b32 v54, 16, v57
  v_and_b32 v55, s20, v57
  v_lshlrev_b32 v56, 16, v58
  v_and_b32 v57, s20, v58
  v_lshlrev_b32 v58, 16, v59
  v_and_b32 v59, s20, v59
  v_pk_fma_f32 v[84:85], v[52:53], v[52:53], v[84:85]
  v_pk_fma_f32 v[86:87], v[54:55], v[54:55], v[86:87]
  v_pk_fma_f32 v[88:89], v[56:57], v[56:57], v[88:89]
  v_pk_fma_f32 v[90:91], v[58:59], v[58:59], v[90:91]
  s_waitcnt vmcnt(0)
  v_lshlrev_b32 v60, 16, v64
  v_and_b32 v61, s20, v64
  v_lshlrev_b32 v62, 16, v65
  v_and_b32 v63, s20, v65
  v_lshlrev_b32 v64, 16, v66
  v_and_b32 v65, s20, v66
  v_lshlrev_b32 v66, 16, v67
  v_and_b32 v67, s20, v67
  v_pk_fma_f32 v[84:85], v[60:61], v[60:61], v[84:85]
  v_pk_fma_f32 v[86:87], v[62:63], v[62:63], v[86:87]
  v_pk_fma_f32 v[88:89], v[64:65], v[64:65], v[88:89]
  v_pk_fma_f32 v[90:91], v[66:67], v[66:67], v[90:91]
  s_nop 1
  v_permlane32_swap_b32 v84, v88
  v_permlane32_swap_b32 v85, v89
  v_permlane32_swap_b32 v86, v90
  v_permlane32_swap_b32 v87, v91
  v_pk_add_f32 v[84:85], v[84:85], v[88:89]
  v_pk_add_f32 v[86:87], v[86:87], v[90:91]
  v_sqrt_f32 v84, v84
  v_sqrt_f32 v85, v85
  v_sqrt_f32 v86, v86
  v_sqrt_f32 v87, v87
  s_nop 0
  v_pk_add_f32 v[2:3], v[84:85], v[86:87]
  v_add_f32 v2, v2, v3
  v_mov_b32 v88, v84
  v_mov_b32 v89, v85
  v_add_f32_dpp v2, v2, v2 quad_perm:[1,0,3,2] row_mask:0xf bank_mask:0xf
  v_mov_b32 v90, v86
  v_mov_b32 v91, v87
  v_add_f32_dpp v2, v2, v2 quad_perm:[2,3,0,1] row_mask:0xf bank_mask:0xf
  s_nop 1
  v_add_f32_dpp v2, v2, v2 row_half_mirror row_mask:0xf bank_mask:0xf
  v_permlane32_swap_b32 v84, v88
  v_permlane32_swap_b32 v85, v89
  v_add_f32_dpp v2, v2, v2 row_mirror row_mask:0xf bank_mask:0xf
  v_permlane32_swap_b32 v86, v90
  v_permlane32_swap_b32 v87, v91
  v_add_f32_dpp v2, v2, v2 row_bcast:15 row_mask:0xa bank_mask:0xf
  s_nop 1
  v_add_f32_dpp v2, v2, v2 row_bcast:31 row_mask:0xc bank_mask:0xf
  s_mov_b32 exec_lo, 0
  s_brev_b32 exec_hi, 1
  ds_write_b32 v0, v2
  s_mov_b64 exec, -1
  v_pk_mul_f32 v[84:85], v[84:85], v[68:69]
  v_pk_mul_f32 v[86:87], v[86:87], v[70:71]
  v_pk_mul_f32 v[88:89], v[88:89], v[72:73]
  v_pk_mul_f32 v[90:91], v[90:91], v[74:75]
  v_mov_b32 v2, 0
  v_mov_b32 v3, 0x358637bd
  s_waitcnt lgkmcnt(0)
  s_barrier
  ds_read_b128 v[68:71], v2
  s_waitcnt lgkmcnt(0)
  v_pk_add_f32 v[68:69], v[68:69], v[70:71]
  v_add_f32 v2, v68, v69
  v_fmac_f32 v3, 0x3a800000, v2
  v_rcp_f32 v2, v3
  s_nop 0
  v_pk_fma_f32 v[84:85], v[84:85], v[2:3], 1.0 op_sel_hi:[1,0,0]
  v_pk_fma_f32 v[86:87], v[86:87], v[2:3], 1.0 op_sel_hi:[1,0,0]
  v_pk_fma_f32 v[88:89], v[88:89], v[2:3], 1.0 op_sel_hi:[1,0,0]
  v_pk_fma_f32 v[90:91], v[90:91], v[2:3], 1.0 op_sel_hi:[1,0,0]
  v_pk_fma_f32 v[4:5], v[4:5], v[84:85], v[76:77]
  v_pk_fma_f32 v[6:7], v[6:7], v[86:87], v[78:79]
  v_pk_fma_f32 v[8:9], v[8:9], v[88:89], v[80:81]
  v_pk_fma_f32 v[10:11], v[10:11], v[90:91], v[82:83]
  v_cvt_pk_bf16_f32 v4, v4, v5
  v_cvt_pk_bf16_f32 v5, v6, v7
  v_cvt_pk_bf16_f32 v6, v8, v9
  v_cvt_pk_bf16_f32 v7, v10, v11
  v_pk_fma_f32 v[12:13], v[12:13], v[84:85], v[76:77]
  v_pk_fma_f32 v[14:15], v[14:15], v[86:87], v[78:79]
  v_pk_fma_f32 v[16:17], v[16:17], v[88:89], v[80:81]
  v_pk_fma_f32 v[18:19], v[18:19], v[90:91], v[82:83]
  v_cvt_pk_bf16_f32 v12, v12, v13
  v_cvt_pk_bf16_f32 v13, v14, v15
  v_cvt_pk_bf16_f32 v14, v16, v17
  v_cvt_pk_bf16_f32 v15, v18, v19
  v_pk_fma_f32 v[20:21], v[20:21], v[84:85], v[76:77]
  v_pk_fma_f32 v[22:23], v[22:23], v[86:87], v[78:79]
  v_pk_fma_f32 v[24:25], v[24:25], v[88:89], v[80:81]
  v_pk_fma_f32 v[26:27], v[26:27], v[90:91], v[82:83]
  v_cvt_pk_bf16_f32 v20, v20, v21
  v_cvt_pk_bf16_f32 v21, v22, v23
  v_cvt_pk_bf16_f32 v22, v24, v25
  v_cvt_pk_bf16_f32 v23, v26, v27
  v_pk_fma_f32 v[28:29], v[28:29], v[84:85], v[76:77]
  v_pk_fma_f32 v[30:31], v[30:31], v[86:87], v[78:79]
  v_pk_fma_f32 v[32:33], v[32:33], v[88:89], v[80:81]
  v_pk_fma_f32 v[34:35], v[34:35], v[90:91], v[82:83]
  v_cvt_pk_bf16_f32 v28, v28, v29
  v_cvt_pk_bf16_f32 v29, v30, v31
  v_cvt_pk_bf16_f32 v30, v32, v33
  v_cvt_pk_bf16_f32 v31, v34, v35
  v_pk_fma_f32 v[36:37], v[36:37], v[84:85], v[76:77]
  v_pk_fma_f32 v[38:39], v[38:39], v[86:87], v[78:79]
  v_pk_fma_f32 v[40:41], v[40:41], v[88:89], v[80:81]
  v_pk_fma_f32 v[42:43], v[42:43], v[90:91], v[82:83]
  v_cvt_pk_bf16_f32 v36, v36, v37
  v_cvt_pk_bf16_f32 v37, v38, v39
  v_cvt_pk_bf16_f32 v38, v40, v41
  v_cvt_pk_bf16_f32 v39, v42, v43
  v_pk_fma_f32 v[44:45], v[44:45], v[84:85], v[76:77]
  v_pk_fma_f32 v[46:47], v[46:47], v[86:87], v[78:79]
  v_pk_fma_f32 v[48:49], v[48:49], v[88:89], v[80:81]
  v_pk_fma_f32 v[50:51], v[50:51], v[90:91], v[82:83]
  v_cvt_pk_bf16_f32 v44, v44, v45
  v_cvt_pk_bf16_f32 v45, v46, v47
  v_cvt_pk_bf16_f32 v46, v48, v49
  v_cvt_pk_bf16_f32 v47, v50, v51
  v_pk_fma_f32 v[52:53], v[52:53], v[84:85], v[76:77]
  v_pk_fma_f32 v[54:55], v[54:55], v[86:87], v[78:79]
  v_pk_fma_f32 v[56:57], v[56:57], v[88:89], v[80:81]
  v_pk_fma_f32 v[58:59], v[58:59], v[90:91], v[82:83]
  v_cvt_pk_bf16_f32 v52, v52, v53
  v_cvt_pk_bf16_f32 v53, v54, v55
  v_cvt_pk_bf16_f32 v54, v56, v57
  v_cvt_pk_bf16_f32 v55, v58, v59
  v_pk_fma_f32 v[60:61], v[60:61], v[84:85], v[76:77]
  v_pk_fma_f32 v[62:63], v[62:63], v[86:87], v[78:79]
  v_pk_fma_f32 v[64:65], v[64:65], v[88:89], v[80:81]
  v_pk_fma_f32 v[66:67], v[66:67], v[90:91], v[82:83]
  v_cvt_pk_bf16_f32 v60, v60, v61
  v_cvt_pk_bf16_f32 v61, v62, v63
  v_cvt_pk_bf16_f32 v62, v64, v65
  v_cvt_pk_bf16_f32 v63, v66, v67
  s_bitcmp1_b32 s2, 0
  s_cbranch_scc1 L_keep
  buffer_store_dwordx4 v[4:7], v1, s[16:19], 0 offen sc1 nt
  buffer_store_dwordx4 v[12:15], v1, s[16:19], s21 offen sc1 nt
  buffer_store_dwordx4 v[20:23], v1, s[16:19], s22 offen sc1 nt
  buffer_store_dwordx4 v[28:31], v1, s[16:19], s23 offen sc1 nt
  buffer_store_dwordx4 v[36:39], v1, s[16:19], s24 offen sc1 nt
  buffer_store_dwordx4 v[44:47], v1, s[16:19], s25 offen sc1 nt
  buffer_store_dwordx4 v[52:55], v1, s[16:19], s26 offen sc1 nt
  buffer_store_dwordx4 v[60:63], v1, s[16:19], s27 offen sc1 nt
  s_endpgm
L_keep:
  buffer_store_dwordx4 v[4:7], v1, s[16:19], 0 offen sc1
  buffer_store_dwordx4 v[12:15], v1, s[16:19], s21 offen sc1
  buffer_store_dwordx4 v[20:23], v1, s[16:19], s22 offen sc1
  buffer_store_dwordx4 v[28:31], v1, s[16:19], s23 offen sc1
  buffer_store_dwordx4 v[36:39], v1, s[16:19], s24 offen sc1
  buffer_store_dwordx4 v[44:47], v1, s[16:19], s25 offen sc1
  buffer_store_dwordx4 v[52:55], v1, s[16:19], s26 offen sc1
  buffer_store_dwordx4 v[60:63], v1, s[16:19], s27 offen sc1
L_end:
  s_endpgm
.section .rodata,"a"
.p2align 6
.amdhsa_kernel standalone__grn__sampling_kernel
  .amdhsa_next_free_vgpr 92
  .amdhsa_next_free_sgpr 32
  .amdhsa_accum_offset 92
  .amdhsa_group_segment_fixed_size 0
  .amdhsa_kernarg_size 48
  .amdhsa_user_sgpr_count 2
  .amdhsa_user_sgpr_kernarg_segment_ptr 1
  .amdhsa_system_sgpr_workgroup_id_x 1
  .amdhsa_float_denorm_mode_32 3
.end_amdhsa_kernel
```
